```python
import torch

def _softmax(x, axis=-1):
    return torch.softmax(x, dim=axis)
def _gelu(x):
    return torch.nn.functional.gelu(x, approximate="tanh")
def _silu(x):
    return torch.nn.functional.silu(x)
def _sigmoid(x):
    return torch.sigmoid(x)
def _layernorm(x, axis=-1, eps=1e-5):
    m = x.mean(dim=axis, keepdim=True)
    v = x.var(dim=axis, keepdim=True, unbiased=False)
    return (x - m) / torch.sqrt(v + eps)
def _scatter_add(tgt, idx, src, axis=0):
    return tgt.clone().index_add_(axis, idx, src)
def _segment_sum(src, seg, n):
    out = torch.zeros((n,) + src.shape[1:], dtype=src.dtype)
    return out.index_add_(0, seg, src)
def _pad(x, pw):
    flat = tuple(v for pair in reversed(pw) for v in pair)
    return torch.nn.functional.pad(x, flat)

kernel_name = 'standalone__instancenorm__sampling'

def setup_inputs():

    _w = (lambda a: (lambda t: t.to(torch.bfloat16) if t.is_floating_point() else t)(torch.as_tensor(a)))
    B, C, H, W = 32, 512, 16, 32
    return {
        "x": _w(abs((lambda *s: torch.randn(*s, dtype=torch.bfloat16) * 0.05)(B, C, H, W))),
        "g": _w((lambda *s: torch.randn(*s, dtype=torch.bfloat16) * 0.05)(C) + 1.0),
        "b": _w((lambda *s: torch.randn(*s, dtype=torch.bfloat16) * 0.4)(C)),
    }

def reference(x, g, b):
    mu = x.mean(axis=(-2, -1), keepdims=True)
    var = ((x - mu) ** 2).mean(axis=(-2, -1), keepdims=True)
    xhat = (x - mu) / torch.sqrt(var + 1e-5)
    return xhat * g.reshape(1, -1, 1, 1) + b.reshape(1, -1, 1, 1)
```

```asm
; @launch grid=(256,1,1) block=(1024,1,1) lds=0
.amdgcn_target "amdgcn-amd-amdhsa--gfx950"
.text
.globl standalone__instancenorm__sampling_kernel
.p2align 12
.p2align 8
.type standalone__instancenorm__sampling_kernel,@function
standalone__instancenorm__sampling_kernel:
    s_load_dwordx8 s[4:11], s[0:1], 0
    s_lshr_b32 s3, s2, 3
    s_cmp_ge_u32 s3, 32
    s_cbranch_scc1 L_end
    s_and_b32 s12, s2, 7
    s_lshl_b32 s12, s12, 5
    s_or_b32 s3, s3, s12
    s_lshl_b32 s15, s3, 6
    s_and_b32 s3, s3, 15
    s_lshl2_add_u32 s3, s3, s15
    v_lshrrev_b32 v2, 4, v0
    v_lshrrev_b32 v3, 2, v0
    v_and_b32 v3, 12, v3
    v_xor_b32 v2, v2, v3
    v_xor_b32 v2, s3, v2
    v_and_b32 v1, 15, v0
    v_lshlrev_b32 v1, 4, v1
    v_lshl_add_u32 v1, v2, 10, v1
    s_waitcnt lgkmcnt(0)
    global_load_dwordx4 v[8:11], v1, s[4:5] offset:0 nt
    global_load_dwordx4 v[12:15], v1, s[4:5] offset:256 nt
    global_load_dwordx4 v[16:19], v1, s[4:5] offset:512 nt
    global_load_dwordx4 v[20:23], v1, s[4:5] offset:768 nt
    v_and_b32 v2, 0x1ff, v2
    v_lshlrev_b32 v2, 1, v2
    v_mov_b64 v[4:5], 0
    global_load_short_d16_hi v4, v2, s[6:7]
    global_load_short_d16_hi v5, v2, s[8:9]
    v_readfirstlane_b32 s14, v0
    v_mov_b64 v[56:57], 0
    s_mov_b32 s13, 0x3f803f80
    s_mov_b32 s12, 0xffff0000
    s_cmpk_lt_u32 s14, 384
    s_cbranch_scc1 L_early
    s_barrier
L_early:
    s_waitcnt vmcnt(5)
    v_dot2c_f32_bf16 v56, s13, v8
    v_dot2c_f32_bf16 v57, s13, v9
    v_dot2c_f32_bf16 v56, s13, v10
    v_dot2c_f32_bf16 v57, s13, v11
    v_lshlrev_b32 v24, 16, v8
    v_and_b32 v25, s12, v8
    v_lshlrev_b32 v26, 16, v9
    v_and_b32 v27, s12, v9
    v_lshlrev_b32 v28, 16, v10
    v_and_b32 v29, s12, v10
    v_lshlrev_b32 v30, 16, v11
    v_and_b32 v31, s12, v11
    s_waitcnt vmcnt(4)
    v_dot2c_f32_bf16 v56, s13, v12
    v_dot2c_f32_bf16 v57, s13, v13
    v_dot2c_f32_bf16 v56, s13, v14
    v_dot2c_f32_bf16 v57, s13, v15
    v_lshlrev_b32 v32, 16, v12
    v_and_b32 v33, s12, v12
    v_lshlrev_b32 v34, 16, v13
    v_and_b32 v35, s12, v13
    v_lshlrev_b32 v36, 16, v14
    v_and_b32 v37, s12, v14
    v_lshlrev_b32 v38, 16, v15
    v_and_b32 v39, s12, v15
    s_waitcnt vmcnt(3)
    v_dot2c_f32_bf16 v56, s13, v16
    v_dot2c_f32_bf16 v57, s13, v17
    v_dot2c_f32_bf16 v56, s13, v18
    v_dot2c_f32_bf16 v57, s13, v19
    v_lshlrev_b32 v40, 16, v16
    v_and_b32 v41, s12, v16
    v_lshlrev_b32 v42, 16, v17
    v_and_b32 v43, s12, v17
    v_lshlrev_b32 v44, 16, v18
    v_and_b32 v45, s12, v18
    v_lshlrev_b32 v46, 16, v19
    v_and_b32 v47, s12, v19
    s_waitcnt vmcnt(2)
    v_dot2c_f32_bf16 v56, s13, v20
    v_dot2c_f32_bf16 v57, s13, v21
    v_dot2c_f32_bf16 v56, s13, v22
    v_dot2c_f32_bf16 v57, s13, v23
    v_lshlrev_b32 v48, 16, v20
    v_and_b32 v49, s12, v20
    s_nop 0
    v_add_f32 v56, v56, v57
    v_lshlrev_b32 v50, 16, v21
    v_and_b32 v51, s12, v21
    v_add_f32_dpp v56, v56, v56 row_ror:8 row_mask:0xf bank_mask:0xf
    v_lshlrev_b32 v52, 16, v22
    v_and_b32 v53, s12, v22
    v_add_f32_dpp v56, v56, v56 row_ror:4 row_mask:0xf bank_mask:0xf
    v_lshlrev_b32 v54, 16, v23
    v_and_b32 v55, s12, v23
    v_add_f32_dpp v56, v56, v56 row_ror:2 row_mask:0xf bank_mask:0xf
    s_nop 1
    v_add_f32_dpp v56, v56, v56 row_ror:1 row_mask:0xf bank_mask:0xf
    v_mul_f32 v56, 0xbb000000, v56
    v_cvt_pk_bf16_f32 v56, 0, v56
    v_pk_add_f32 v[24:25], v[24:25], v[56:57] op_sel_hi:[1,0]
    v_pk_add_f32 v[26:27], v[26:27], v[56:57] op_sel_hi:[1,0]
    v_pk_add_f32 v[28:29], v[28:29], v[56:57] op_sel_hi:[1,0]
    v_pk_mul_f32 v[58:59], v[24:25], v[24:25]
    v_pk_add_f32 v[30:31], v[30:31], v[56:57] op_sel_hi:[1,0]
    v_pk_mul_f32 v[60:61], v[26:27], v[26:27]
    v_pk_add_f32 v[32:33], v[32:33], v[56:57] op_sel_hi:[1,0]
    v_pk_fma_f32 v[58:59], v[28:29], v[28:29], v[58:59]
    v_pk_add_f32 v[34:35], v[34:35], v[56:57] op_sel_hi:[1,0]
    v_pk_fma_f32 v[60:61], v[30:31], v[30:31], v[60:61]
    v_pk_add_f32 v[36:37], v[36:37], v[56:57] op_sel_hi:[1,0]
    v_pk_fma_f32 v[58:59], v[32:33], v[32:33], v[58:59]
    v_pk_add_f32 v[38:39], v[38:39], v[56:57] op_sel_hi:[1,0]
    v_pk_fma_f32 v[60:61], v[34:35], v[34:35], v[60:61]
    v_pk_add_f32 v[40:41], v[40:41], v[56:57] op_sel_hi:[1,0]
    v_pk_fma_f32 v[58:59], v[36:37], v[36:37], v[58:59]
    v_pk_add_f32 v[42:43], v[42:43], v[56:57] op_sel_hi:[1,0]
    v_pk_fma_f32 v[60:61], v[38:39], v[38:39], v[60:61]
    v_pk_add_f32 v[44:45], v[44:45], v[56:57] op_sel_hi:[1,0]
    v_pk_fma_f32 v[58:59], v[40:41], v[40:41], v[58:59]
    v_pk_add_f32 v[46:47], v[46:47], v[56:57] op_sel_hi:[1,0]
    v_pk_fma_f32 v[60:61], v[42:43], v[42:43], v[60:61]
    v_pk_add_f32 v[48:49], v[48:49], v[56:57] op_sel_hi:[1,0]
    v_pk_fma_f32 v[58:59], v[44:45], v[44:45], v[58:59]
    v_pk_add_f32 v[50:51], v[50:51], v[56:57] op_sel_hi:[1,0]
    v_pk_fma_f32 v[60:61], v[46:47], v[46:47], v[60:61]
    v_pk_add_f32 v[52:53], v[52:53], v[56:57] op_sel_hi:[1,0]
    v_pk_fma_f32 v[58:59], v[48:49], v[48:49], v[58:59]
    v_pk_add_f32 v[54:55], v[54:55], v[56:57] op_sel_hi:[1,0]
    v_pk_fma_f32 v[60:61], v[50:51], v[50:51], v[60:61]
    v_pk_fma_f32 v[58:59], v[52:53], v[52:53], v[58:59]
    v_pk_fma_f32 v[60:61], v[54:55], v[54:55], v[60:61]
    v_pk_add_f32 v[58:59], v[58:59], v[60:61]
    v_add_f32 v58, v58, v59
    s_nop 1
    v_add_f32_dpp v58, v58, v58 row_ror:8 row_mask:0xf bank_mask:0xf
    s_nop 1
    v_add_f32_dpp v58, v58, v58 row_ror:4 row_mask:0xf bank_mask:0xf
    s_nop 1
    v_add_f32_dpp v58, v58, v58 row_ror:2 row_mask:0xf bank_mask:0xf
    s_nop 1
    v_add_f32_dpp v58, v58, v58 row_ror:1 row_mask:0xf bank_mask:0xf
    v_mul_f32 v58, 0x3b000000, v58
    v_cvt_pk_bf16_f32 v58, 0, v58
    v_add_f32 v58, 0x3727c5ac, v58
    v_cvt_pk_bf16_f32 v58, 0, v58
    v_sqrt_f32 v58, v58
    s_nop 0
    v_cvt_pk_bf16_f32 v58, 0, v58
    v_rcp_f32 v58, v58
    s_waitcnt vmcnt(0)
    v_mul_f32 v4, v4, v58
    v_pk_fma_f32 v[24:25], v[24:25], v[4:5], v[4:5] op_sel:[0,0,1] op_sel_hi:[1,0,1]
    v_pk_fma_f32 v[26:27], v[26:27], v[4:5], v[4:5] op_sel:[0,0,1] op_sel_hi:[1,0,1]
    v_pk_fma_f32 v[28:29], v[28:29], v[4:5], v[4:5] op_sel:[0,0,1] op_sel_hi:[1,0,1]
    v_pk_fma_f32 v[30:31], v[30:31], v[4:5], v[4:5] op_sel:[0,0,1] op_sel_hi:[1,0,1]
    v_cvt_pk_bf16_f32 v8, v24, v25
    v_cvt_pk_bf16_f32 v9, v26, v27
    v_cvt_pk_bf16_f32 v10, v28, v29
    v_cvt_pk_bf16_f32 v11, v30, v31
    v_pk_fma_f32 v[32:33], v[32:33], v[4:5], v[4:5] op_sel:[0,0,1] op_sel_hi:[1,0,1]
    v_pk_fma_f32 v[34:35], v[34:35], v[4:5], v[4:5] op_sel:[0,0,1] op_sel_hi:[1,0,1]
    v_pk_fma_f32 v[36:37], v[36:37], v[4:5], v[4:5] op_sel:[0,0,1] op_sel_hi:[1,0,1]
    v_pk_fma_f32 v[38:39], v[38:39], v[4:5], v[4:5] op_sel:[0,0,1] op_sel_hi:[1,0,1]
    v_cvt_pk_bf16_f32 v12, v32, v33
    v_cvt_pk_bf16_f32 v13, v34, v35
    v_cvt_pk_bf16_f32 v14, v36, v37
    v_cvt_pk_bf16_f32 v15, v38, v39
    v_pk_fma_f32 v[40:41], v[40:41], v[4:5], v[4:5] op_sel:[0,0,1] op_sel_hi:[1,0,1]
    v_pk_fma_f32 v[42:43], v[42:43], v[4:5], v[4:5] op_sel:[0,0,1] op_sel_hi:[1,0,1]
    v_pk_fma_f32 v[44:45], v[44:45], v[4:5], v[4:5] op_sel:[0,0,1] op_sel_hi:[1,0,1]
    v_pk_fma_f32 v[46:47], v[46:47], v[4:5], v[4:5] op_sel:[0,0,1] op_sel_hi:[1,0,1]
    v_cvt_pk_bf16_f32 v16, v40, v41
    v_cvt_pk_bf16_f32 v17, v42, v43
    v_cvt_pk_bf16_f32 v18, v44, v45
    v_cvt_pk_bf16_f32 v19, v46, v47
    v_pk_fma_f32 v[48:49], v[48:49], v[4:5], v[4:5] op_sel:[0,0,1] op_sel_hi:[1,0,1]
    v_pk_fma_f32 v[50:51], v[50:51], v[4:5], v[4:5] op_sel:[0,0,1] op_sel_hi:[1,0,1]
    v_pk_fma_f32 v[52:53], v[52:53], v[4:5], v[4:5] op_sel:[0,0,1] op_sel_hi:[1,0,1]
    v_pk_fma_f32 v[54:55], v[54:55], v[4:5], v[4:5] op_sel:[0,0,1] op_sel_hi:[1,0,1]
    v_cvt_pk_bf16_f32 v20, v48, v49
    v_cvt_pk_bf16_f32 v21, v50, v51
    v_cvt_pk_bf16_f32 v22, v52, v53
    v_cvt_pk_bf16_f32 v23, v54, v55
    s_cbranch_scc0 L_late
    s_barrier
L_late:
    global_store_dwordx4 v1, v[8:11], s[10:11] offset:0 nt
    global_store_dwordx4 v1, v[12:15], s[10:11] offset:256 nt
    global_store_dwordx4 v1, v[16:19], s[10:11] offset:512 nt
    global_store_dwordx4 v1, v[20:23], s[10:11] offset:768 nt
L_end:
    s_endpgm
.section .rodata,"a"
.p2align 6
.amdhsa_kernel standalone__instancenorm__sampling_kernel
  .amdhsa_next_free_vgpr 72
  .amdhsa_next_free_sgpr 16
  .amdhsa_accum_offset 72
  .amdhsa_group_segment_fixed_size 0
  .amdhsa_kernarg_size 48
  .amdhsa_user_sgpr_count 2
  .amdhsa_user_sgpr_kernarg_segment_ptr 1
  .amdhsa_system_sgpr_workgroup_id_x 1
  .amdhsa_float_denorm_mode_32 3
.end_amdhsa_kernel
```
